```python
import torch

def _softmax(x, axis=-1):
    return torch.softmax(x, dim=axis)
def _gelu(x):
    return torch.nn.functional.gelu(x, approximate="tanh")
def _silu(x):
    return torch.nn.functional.silu(x)
def _sigmoid(x):
    return torch.sigmoid(x)
def _layernorm(x, axis=-1, eps=1e-5):
    m = x.mean(dim=axis, keepdim=True)
    v = x.var(dim=axis, keepdim=True, unbiased=False)
    return (x - m) / torch.sqrt(v + eps)
def _scatter_add(tgt, idx, src, axis=0):
    return tgt.clone().index_add_(axis, idx, src)
def _segment_sum(src, seg, n):
    out = torch.zeros((n,) + src.shape[1:], dtype=src.dtype)
    return out.index_add_(0, seg, src)
def _pad(x, pw):
    flat = tuple(v for pair in reversed(pw) for v in pair)
    return torch.nn.functional.pad(x, flat)

kernel_name = 'standalone__dense_activation_relu__prompt'

def setup_inputs():

    _w = (lambda a: (lambda t: t.to(torch.bfloat16) if t.is_floating_point() else t)(torch.as_tensor(a)))
    B, S, D, Dff = 1, 2048, 448, 1792
    return {
        "x": _w((lambda *s: torch.randn(*s, dtype=torch.bfloat16) * 0.05)(B, S, D)),
        "w1": _w((lambda *s: torch.randn(*s, dtype=torch.bfloat16) * 0.05)(D, Dff)),
        "w2": _w((lambda *s: torch.randn(*s, dtype=torch.bfloat16) * 0.05)(Dff, D)),
    }

def reference(x, w1, w2):
    h = torch.einsum("bsd,df->bsf", x, w1)
    zero = torch.zeros_like(h)
    h = torch.maximum(h, zero)
    return torch.einsum("bsf,fd->bsd", h, w2)
```

```asm
; @launch grid=(256,1,1) block=(512,1,1) lds=163840
.amdgcn_target "amdgcn-amd-amdhsa--gfx950"
.text
.globl standalone__dense_activation_relu__prompt_kernel
.p2align 8
.type standalone__dense_activation_relu__prompt_kernel,@function
standalone__dense_activation_relu__prompt_kernel:
    s_cmp_ge_u32 s2, 256
    s_cbranch_scc1 L_end
    s_load_dwordx8 s[4:11], s[0:1], 0
    s_load_dwordx4 s[12:15], s[0:1], 32
    s_getpc_b64 s[58:59]
L_pc:
    v_lshlrev_b32 v5, 7, v0
    v_min_u32 v5, L_code_end-L_pc-4, v5
    v_lshrrev_b32 v2, 6, v0
    global_load_dword v47, v5, s[58:59]
    v_and_b32 v1, 63, v0
    s_and_b32 s36, s2, 7
    v_readfirstlane_b32 s3, v2
    s_lshr_b32 s37, s2, 3
    s_cmp_ge_u32 s2, 224
    s_cbranch_scc1 L_helper
    s_mul_i32 s38, s37, 37
    s_lshr_b32 s38, s38, 8
    s_mul_i32 s39, s38, 7
    s_sub_u32 s39, s37, s39
    s_lshr_b32 s40, s36, 1
    s_lshl_b32 s40, s40, 2
    s_add_u32 s40, s40, s38
    s_and_b32 s41, s36, 1
    s_mul_i32 s41, s41, 7
    s_add_u32 s41, s41, s39
    v_and_b32 v2, 3, v2
    v_lshrrev_b32 v3, 3, v1
    v_and_b32 v4, 7, v1
    s_and_b32 s43, s3, 3
    s_cmp_lt_u32 s3, 4
    s_cbranch_scc1 L_compute
    v_lshl_add_u32 v5, v2, 5, v3
    v_mul_u32_u24 v7, 896, v5
    v_lshrrev_b32 v6, 1, v3
    v_xor_b32 v8, v6, v4
    v_lshl_add_u32 v10, v8, 4, v7
    v_xor_b32 v8, 4, v8
    v_lshl_add_u32 v11, v8, 4, v7
    v_add_u32 v11, 6144, v11
    v_add_u32 v12, 12288, v10
    v_add_u32 v13, 12288, v11
    v_lshrrev_b32 v9, 4, v1
    v_and_b32 v22, 15, v1
    v_lshl_add_u32 v5, v2, 4, v9
    v_mul_u32_u24 v7, 3584, v5
    v_lshlrev_b32 v6, 2, v9
    v_xor_b32 v8, v6, v22
    v_lshl_add_u32 v14, v8, 4, v7
    v_add_u32 v15, 13312, v14
    v_add_u32 v16, 26624, v14
    v_add_u32 v17, 39936, v14
    s_lshl_b32 s45, s43, 12
    s_add_u32 s46, s38, s39
    s_bitcmp1_b32 s46, 0
    s_mov_b32 s57, 0x3654210
    s_cselect_b32 s57, 0x2654310, s57
    s_mov_b32 s44, 0x3210654
    s_cselect_b32 s44, 0x3621054, s44
    s_bitcmp1_b32 s46, 1
    s_cselect_b32 s57, s44, s57
    s_lshr_b32 s44, s36, 1
    s_lshl_b32 s46, s36, 1
    s_add_u32 s44, s44, s46
    s_and_b32 s44, s44, 3
    s_mul_i32 s44, s44, 0x1111111
    s_add_u32 s57, s57, s44
    s_add_u32 s44, s57, 0x1111111
    s_and_b32 s44, s44, 0x8888888
    s_lshr_b32 s44, s44, 3
    s_mul_i32 s44, s44, 7
    s_sub_u32 s57, s57, s44
    s_mul_i32 s44, s40, 114688
    s_lshl_b32 s49, s41, 8
    s_mov_b32 s18, 114688
    s_mov_b32 s19, 0x20000
    s_sub_u32 s22, 1605632, s49
    s_mov_b32 s23, 0x20000
    s_waitcnt lgkmcnt(0)
    s_add_u32 s16, s4, s44
    s_addc_u32 s17, s5, 0
    s_add_u32 s20, s6, s49
    s_addc_u32 s21, s7, 0
    s_bfe_u32 s46, s57, 0x30000
    s_lshl_b32 s49, s46, 7
    s_add_u32 m0, s45, 0
    s_mul_i32 s50, s46, 229376
    buffer_load_dwordx4 v10, s[16:19], s49 offen lds
    buffer_load_dwordx4 v11, s[16:19], s49 offen offset:1024 lds
    buffer_load_dwordx4 v12, s[16:19], s49 offen offset:2048 lds
    buffer_load_dwordx4 v13, s[16:19], s49 offen offset:3072 lds
    s_add_u32 m0, s45, 16384
    s_nop 0
    buffer_load_dwordx4 v14, s[20:23], s50 offen lds
    buffer_load_dwordx4 v15, s[20:23], s50 offen offset:1024 lds
    buffer_load_dwordx4 v16, s[20:23], s50 offen offset:2048 lds
    buffer_load_dwordx4 v17, s[20:23], s50 offen offset:3072 lds
    v_mul_u32_u24 v5, 448, v2
    v_add_u32 v5, v5, v3
    v_mul_u32_u24 v7, 896, v5
    v_bfe_u32 v6, v1, 4, 1
    v_lshlrev_b32 v6, 2, v6
    v_xor_b32 v8, v6, v4
    v_lshl_add_u32 v18, v8, 4, v7
    v_add_u32 v19, 6144, v18
    v_add_u32 v20, 12288, v18
    v_add_u32 v21, 18432, v18
    s_lshl_b32 s44, s39, 7
    s_add_u32 s24, s8, s44
    s_addc_u32 s25, s9, 0
    s_sub_u32 s26, 1605632, s44
    s_mov_b32 s27, 0x20000
    s_lshl_b32 s51, s43, 13
    s_mov_b32 s47, s36
    s_cmp_ge_u32 s47, 7
    s_cselect_b32 s44, 7, 0
    s_sub_u32 s47, s47, s44
    s_mov_b32 s48, 0x6524130
    s_cmp_eq_u32 s38, 1
    s_cselect_b32 s48, 0x6504231, s48
    s_cmp_eq_u32 s38, 2
    s_cselect_b32 s48, 0x6514032, s48
    s_cmp_eq_u32 s38, 3
    s_cselect_b32 s48, 0x6524130, s48
    s_mul_i32 s44, s47, 0x1111111
    s_add_u32 s48, s48, s44
    s_add_u32 s44, s48, 0x1111111
    s_and_b32 s44, s44, 0x8888888
    s_lshr_b32 s44, s44, 3
    s_mul_i32 s44, s44, 7
    s_sub_u32 s48, s48, s44
    s_bfe_u32 s46, s57, 0x30004
    s_lshl_b32 s49, s46, 7
    s_add_u32 m0, s45, 32768
    s_mul_i32 s50, s46, 229376
    buffer_load_dwordx4 v10, s[16:19], s49 offen lds
    buffer_load_dwordx4 v11, s[16:19], s49 offen offset:1024 lds
    buffer_load_dwordx4 v12, s[16:19], s49 offen offset:2048 lds
    buffer_load_dwordx4 v13, s[16:19], s49 offen offset:3072 lds
    s_add_u32 m0, s45, 49152
    s_nop 0
    buffer_load_dwordx4 v14, s[20:23], s50 offen lds
    buffer_load_dwordx4 v15, s[20:23], s50 offen offset:1024 lds
    buffer_load_dwordx4 v16, s[20:23], s50 offen offset:2048 lds
    buffer_load_dwordx4 v17, s[20:23], s50 offen offset:3072 lds
    s_waitcnt vmcnt(8)
    s_barrier
    s_bfe_u32 s46, s57, 0x30008
    s_lshl_b32 s49, s46, 7
    s_add_u32 m0, s45, 65536
    s_mul_i32 s50, s46, 229376
    buffer_load_dwordx4 v10, s[16:19], s49 offen lds
    buffer_load_dwordx4 v11, s[16:19], s49 offen offset:1024 lds
    buffer_load_dwordx4 v12, s[16:19], s49 offen offset:2048 lds
    buffer_load_dwordx4 v13, s[16:19], s49 offen offset:3072 lds
    s_add_u32 m0, s45, 81920
    s_nop 0
    buffer_load_dwordx4 v14, s[20:23], s50 offen lds
    buffer_load_dwordx4 v15, s[20:23], s50 offen offset:1024 lds
    buffer_load_dwordx4 v16, s[20:23], s50 offen offset:2048 lds
    buffer_load_dwordx4 v17, s[20:23], s50 offen offset:3072 lds
    s_bfe_u32 s46, s57, 0x3000c
    s_lshl_b32 s49, s46, 7
    s_add_u32 m0, s45, 98304
    s_mul_i32 s50, s46, 229376
    buffer_load_dwordx4 v10, s[16:19], s49 offen lds
    buffer_load_dwordx4 v11, s[16:19], s49 offen offset:1024 lds
    s_waitcnt vmcnt(10)
    s_barrier
    buffer_load_dwordx4 v12, s[16:19], s49 offen offset:2048 lds
    buffer_load_dwordx4 v13, s[16:19], s49 offen offset:3072 lds
    s_add_u32 m0, s45, 114688
    s_nop 0
    buffer_load_dwordx4 v14, s[20:23], s50 offen lds
    buffer_load_dwordx4 v15, s[20:23], s50 offen offset:1024 lds
    buffer_load_dwordx4 v16, s[20:23], s50 offen offset:2048 lds
    buffer_load_dwordx4 v17, s[20:23], s50 offen offset:3072 lds
    s_bfe_u32 s46, s57, 0x30010
    s_lshl_b32 s49, s46, 7
    s_add_u32 m0, s45, 131072
    s_mul_i32 s50, s46, 229376
    buffer_load_dwordx4 v10, s[16:19], s49 offen lds
    buffer_load_dwordx4 v11, s[16:19], s49 offen offset:1024 lds
    buffer_load_dwordx4 v12, s[16:19], s49 offen offset:2048 lds
    buffer_load_dwordx4 v13, s[16:19], s49 offen offset:3072 lds
    s_waitcnt vmcnt(12)
    s_barrier
    s_add_u32 m0, s45, 147456
    s_nop 0
    buffer_load_dwordx4 v14, s[20:23], s50 offen lds
    buffer_load_dwordx4 v15, s[20:23], s50 offen offset:1024 lds
    buffer_load_dwordx4 v16, s[20:23], s50 offen offset:2048 lds
    buffer_load_dwordx4 v17, s[20:23], s50 offen offset:3072 lds
    s_bfe_u32 s46, s57, 0x30014
    s_lshl_b32 s49, s46, 7
    s_add_u32 m0, s45, 0
    s_mul_i32 s50, s46, 229376
    buffer_load_dwordx4 v10, s[16:19], s49 offen lds
    buffer_load_dwordx4 v11, s[16:19], s49 offen offset:1024 lds
    buffer_load_dwordx4 v12, s[16:19], s49 offen offset:2048 lds
    buffer_load_dwordx4 v13, s[16:19], s49 offen offset:3072 lds
    s_add_u32 m0, s45, 16384
    s_nop 0
    buffer_load_dwordx4 v14, s[20:23], s50 offen lds
    buffer_load_dwordx4 v15, s[20:23], s50 offen offset:1024 lds
    buffer_load_dwordx4 v16, s[20:23], s50 offen offset:2048 lds
    buffer_load_dwordx4 v17, s[20:23], s50 offen offset:3072 lds
    s_waitcnt vmcnt(16)
    s_barrier
    s_bfe_u32 s46, s57, 0x30018
    s_lshl_b32 s49, s46, 7
    s_add_u32 m0, s45, 32768
    s_mul_i32 s50, s46, 229376
    buffer_load_dwordx4 v10, s[16:19], s49 offen lds
    buffer_load_dwordx4 v11, s[16:19], s49 offen offset:1024 lds
    buffer_load_dwordx4 v12, s[16:19], s49 offen offset:2048 lds
    buffer_load_dwordx4 v13, s[16:19], s49 offen offset:3072 lds
    s_add_u32 m0, s45, 49152
    s_nop 0
    buffer_load_dwordx4 v14, s[20:23], s50 offen lds
    buffer_load_dwordx4 v15, s[20:23], s50 offen offset:1024 lds
    buffer_load_dwordx4 v16, s[20:23], s50 offen offset:2048 lds
    buffer_load_dwordx4 v17, s[20:23], s50 offen offset:3072 lds
    s_bfe_u32 s49, s48, 0x30000
    s_mul_i32 s49, s49, 57344
    s_add_u32 m0, s51, 65536
    s_add_u32 s50, s49, 28672
    buffer_load_dwordx4 v18, s[24:27], s49 offen lds
    buffer_load_dwordx4 v19, s[24:27], s49 offen offset:1024 lds
    buffer_load_dwordx4 v20, s[24:27], s49 offen offset:2048 lds
    buffer_load_dwordx4 v21, s[24:27], s49 offen offset:3072 lds
    s_waitcnt vmcnt(20)
    s_barrier
    s_add_u32 m0, s51, 69632
    s_nop 0
    buffer_load_dwordx4 v18, s[24:27], s50 offen lds
    buffer_load_dwordx4 v19, s[24:27], s50 offen offset:1024 lds
    buffer_load_dwordx4 v20, s[24:27], s50 offen offset:2048 lds
    buffer_load_dwordx4 v21, s[24:27], s50 offen offset:3072 lds
    s_waitcnt vmcnt(16)
    s_barrier
    s_bfe_u32 s49, s48, 0x30004
    s_mul_i32 s49, s49, 57344
    s_add_u32 m0, s51, 98304
    s_add_u32 s50, s49, 28672
    buffer_load_dwordx4 v18, s[24:27], s49 offen lds
    buffer_load_dwordx4 v19, s[24:27], s49 offen offset:1024 lds
    buffer_load_dwordx4 v20, s[24:27], s49 offen offset:2048 lds
    buffer_load_dwordx4 v21, s[24:27], s49 offen offset:3072 lds
    s_waitcnt vmcnt(12)
    s_barrier
    s_add_u32 m0, s51, 102400
    s_nop 0
    buffer_load_dwordx4 v18, s[24:27], s50 offen lds
    buffer_load_dwordx4 v19, s[24:27], s50 offen offset:1024 lds
    buffer_load_dwordx4 v20, s[24:27], s50 offen offset:2048 lds
    buffer_load_dwordx4 v21, s[24:27], s50 offen offset:3072 lds
    s_waitcnt vmcnt(0)
    s_barrier
L_end:
    s_endpgm
L_helper:
    s_sub_u32 s38, s37, 28
    s_mul_i32 s38, s38, 401408
    s_mul_i32 s39, s3, 7168
    s_add_u32 s38, s38, s39
    v_min_u32 v4, 55, v1
    v_lshlrev_b32 v4, 7, v4
    s_add_u32 s47, s36, 3
    s_cmp_ge_u32 s47, 7
    s_cselect_b32 s44, 7, 0
    s_sub_u32 s47, s47, s44
    s_mov_b32 s26, 1605632
    s_mov_b32 s27, 0x20000
    s_waitcnt lgkmcnt(0)
    s_mov_b32 s24, s8
    s_mov_b32 s25, s9
    s_mul_i32 s49, s47, 57344
    s_add_u32 s49, s49, s38
    buffer_load_dword v6, v4, s[24:27], s49 offen
    s_waitcnt vmcnt(0)
    s_add_u32 s47, s47, 1
    s_cmp_eq_u32 s47, 7
    s_cselect_b32 s47, 0, s47
    s_mul_i32 s49, s47, 57344
    s_add_u32 s49, s49, s38
    buffer_load_dword v6, v4, s[24:27], s49 offen
    s_waitcnt vmcnt(0)
    s_add_u32 s47, s47, 1
    s_cmp_eq_u32 s47, 7
    s_cselect_b32 s47, 0, s47
    s_mul_i32 s49, s47, 57344
    s_add_u32 s49, s49, s38
    buffer_load_dword v6, v4, s[24:27], s49 offen
    s_waitcnt vmcnt(0)
    s_add_u32 s47, s47, 1
    s_cmp_eq_u32 s47, 7
    s_cselect_b32 s47, 0, s47
    s_mul_i32 s49, s47, 57344
    s_add_u32 s49, s49, s38
    buffer_load_dword v6, v4, s[24:27], s49 offen
    s_waitcnt vmcnt(0)
    s_add_u32 s47, s47, 1
    s_cmp_eq_u32 s47, 7
    s_cselect_b32 s47, 0, s47
    s_endpgm
L_compute:
    s_memrealtime s[60:61]
    s_setprio 1
    s_waitcnt lgkmcnt(0)
    v_mov_b32 v36, 0
    s_or_b32 s44, s2, s43
    s_cmp_lg_u32 s44, 0
    s_cbranch_scc1 L_noepoch
    s_or_b32 s60, s60, 1
    s_atomic_swap s60, s[12:13], 0
L_noepoch:
    v_mul_u32_u24 v5, 448, v2
    v_add_u32 v5, v5, v3
    v_mul_u32_u24 v7, 896, v5
    v_bfe_u32 v6, v1, 4, 1
    v_lshlrev_b32 v6, 2, v6
    v_xor_b32 v8, v6, v4
    v_lshl_add_u32 v18, v8, 4, v7
    v_add_u32 v19, 6144, v18
    v_add_u32 v20, 12288, v18
    v_add_u32 v21, 18432, v18
    s_lshl_b32 s44, s39, 7
    s_add_u32 s24, s8, s44
    s_addc_u32 s25, s9, 0
    s_sub_u32 s26, 1605632, s44
    s_mov_b32 s27, 0x20000
    s_lshl_b32 s51, s43, 13
    s_mov_b32 s47, s36
    s_cmp_ge_u32 s47, 7
    s_cselect_b32 s44, 7, 0
    s_sub_u32 s47, s47, s44
    s_mov_b32 s48, 0x6524130
    s_cmp_eq_u32 s38, 1
    s_cselect_b32 s48, 0x6504231, s48
    s_cmp_eq_u32 s38, 2
    s_cselect_b32 s48, 0x6514032, s48
    s_cmp_eq_u32 s38, 3
    s_cselect_b32 s48, 0x6524130, s48
    s_mul_i32 s44, s47, 0x1111111
    s_add_u32 s48, s48, s44
    s_add_u32 s44, s48, 0x1111111
    s_and_b32 s44, s44, 0x8888888
    s_lshr_b32 s44, s44, 3
    s_mul_i32 s44, s44, 7
    s_sub_u32 s48, s48, s44
    s_lshl_b32 s42, s36, 2
    s_add_u32 s42, s42, s38
    s_mov_b32 s28, s14
    s_mov_b32 s29, s15
    s_mov_b32 s30, 8388608
    s_mov_b32 s31, 0x20000
    s_mov_b32 s32, s10
    s_mov_b32 s33, s11
    s_mov_b32 s34, 1835008
    s_mov_b32 s35, 0x20000
    v_and_b32 v2, 31, v1
    v_lshrrev_b32 v3, 5, v1
    v_bfe_u32 v4, v1, 1, 3
    v_xor_b32 v4, v4, v3
    v_lshlrev_b32 v4, 4, v4
    v_lshl_add_u32 v4, v2, 7, v4
    s_lshr_b32 s52, s43, 1
    s_and_b32 s53, s43, 1
    s_lshl_b32 s44, s52, 13
    v_add_u32 v22, s44, v4
    v_xor_b32 v23, 32, v22
    v_xor_b32 v24, 64, v22
    v_xor_b32 v25, 96, v22
    v_bfe_u32 v5, v1, 2, 2
    v_lshl_add_u32 v6, v3, 3, v5
    v_lshlrev_b32 v6, 8, v6
    v_and_b32 v7, 3, v1
    v_lshlrev_b32 v7, 3, v7
    v_bfe_u32 v8, v1, 4, 1
    v_lshl_add_u32 v7, v8, 5, v7
    s_lshl_b32 s44, s53, 1
    v_xor_b32 v9, s44, v5
    v_lshl_add_u32 v9, v9, 6, v7
    v_add_u32 v26, v9, v6
    v_add_u32 v26, 16384, v26
    v_xor_b32 v27, 64, v26
    v_lshl_add_u32 v6, v3, 2, v5
    v_lshlrev_b32 v6, 7, v6
    v_lshrrev_b32 v9, 1, v5
    v_xor_b32 v9, s52, v9
    v_lshl_add_u32 v9, v9, 6, v7
    v_add3_u32 v28, v9, v6, s51
    v_xor_b32 v29, 64, v28
    v_add_u32 v40, 0x10000, v28
    v_add_u32 v41, 0x10000, v29
    v_add_u32 v42, 0x20000, v28
    v_add_u32 v43, 0x20000, v29
    v_lshlrev_b32 v30, 4, v1
    s_lshl_b32 s44, s53, 10
    v_add_u32 v44, s44, v30
    v_xor_b32 v45, 0x400, v44
    s_lshl_b32 s44, s40, 1
    s_add_u32 s44, s44, s52
    s_mul_i32 s54, s44, 112
    s_lshl_b32 s55, s41, 1
    s_add_u32 s55, s55, s53
    s_lshl_b32 s56, s55, 2
    s_add_u32 s54, s54, s56
    s_lshl_b32 s54, s54, 11
    s_add_u32 s98, s54, 4096
    s_mul_i32 s56, s55, 37
    s_lshr_b32 s56, s56, 8
    s_mul_i32 s57, s56, 7
    s_sub_u32 s57, s55, s57
    s_lshl_b32 s44, s44, 2
    s_add_u32 s44, s44, s56
    s_lshl_b32 s44, s44, 7
    s_lshl_b32 s57, s57, 2
    s_add_u32 s55, s44, s57
    s_add_u32 s55, s55, 8388608
    s_add_u32 s4, s14, s55
    s_addc_u32 s5, s15, 0
    s_mul_i32 s56, s42, 112
    s_mul_i32 s57, s43, 28
    s_add_u32 s56, s56, s57
    s_lshl_b32 s56, s56, 11
    s_lshl_b32 s57, s42, 2
    s_add_u32 s57, s57, s43
    s_lshl_b32 s57, s57, 7
    s_add_u32 s57, s57, 8388608
    s_add_u32 s6, s14, s57
    s_addc_u32 s7, s15, 0
    s_lshl_b32 s44, s42, 6
    s_lshl_b32 s58, s53, 5
    s_add_u32 s44, s44, s58
    s_mul_i32 s44, s44, 896
    s_lshl_b32 s58, s39, 7
    s_add_u32 s44, s44, s58
    s_lshl_b32 s58, s52, 6
    s_add_u32 s99, s44, s58
    v_mul_u32_u24 v38, 896, v2
    v_lshl_add_u32 v38, v3, 4, v38
    v_add_u32 v10, s51, v30
    v_add_u32 v11, 0x10000, v10
    v_xor_b32 v12, 0x2000, v10
    v_xor_b32 v13, 0x4000, v11
    v_xor_b32 v14, 0x6000, v11
    s_waitcnt lgkmcnt(0)
    s_barrier
    ds_read_b64_tr_b16 v[112:113], v26 offset:0
    ds_read_b64_tr_b16 v[114:115], v26 offset:1024
    ds_read_b128 v[116:119], v22 offset:0
    ds_read_b128 v[120:123], v22 offset:4096
    ds_read_b64_tr_b16 v[124:125], v27 offset:0
    ds_read_b64_tr_b16 v[126:127], v27 offset:1024
    s_waitcnt lgkmcnt(3)
    ds_read_b64_tr_b16 v[136:137], v26 offset:4096
    ds_read_b64_tr_b16 v[138:139], v26 offset:5120
    ds_read_b128 v[140:143], v23 offset:0
    v_mfma_f32_32x32x16_bf16 v[48:63], v[112:115], v[116:119], 0
    ds_read_b128 v[144:147], v23 offset:4096
    ds_read_b64_tr_b16 v[148:149], v27 offset:4096
    ds_read_b64_tr_b16 v[150:151], v27 offset:5120
    s_waitcnt lgkmcnt(8)
    v_mfma_f32_32x32x16_bf16 v[64:79], v[112:115], v[120:123], 0
    s_waitcnt lgkmcnt(6)
    v_mfma_f32_32x32x16_bf16 v[96:111], v[124:127], v[120:123], 0
    v_mfma_f32_32x32x16_bf16 v[80:95], v[124:127], v[116:119], 0
    s_waitcnt lgkmcnt(3)
    ds_read_b64_tr_b16 v[112:113], v26 offset:8192
    ds_read_b64_tr_b16 v[114:115], v26 offset:9216
    ds_read_b128 v[116:119], v24 offset:0
    v_mfma_f32_32x32x16_bf16 v[48:63], v[136:139], v[140:143], v[48:63]
    ds_read_b128 v[120:123], v24 offset:4096
    ds_read_b64_tr_b16 v[124:125], v27 offset:8192
    ds_read_b64_tr_b16 v[126:127], v27 offset:9216
    s_waitcnt lgkmcnt(8)
    v_mfma_f32_32x32x16_bf16 v[64:79], v[136:139], v[144:147], v[64:79]
    s_waitcnt lgkmcnt(6)
    v_mfma_f32_32x32x16_bf16 v[96:111], v[148:151], v[144:147], v[96:111]
    v_mfma_f32_32x32x16_bf16 v[80:95], v[148:151], v[140:143], v[80:95]
    s_waitcnt lgkmcnt(3)
    ds_read_b64_tr_b16 v[136:137], v26 offset:12288
    ds_read_b64_tr_b16 v[138:139], v26 offset:13312
    ds_read_b128 v[140:143], v25 offset:0
    v_mfma_f32_32x32x16_bf16 v[48:63], v[112:115], v[116:119], v[48:63]
    ds_read_b128 v[144:147], v25 offset:4096
    ds_read_b64_tr_b16 v[148:149], v27 offset:12288
    ds_read_b64_tr_b16 v[150:151], v27 offset:13312
    s_waitcnt lgkmcnt(8)
    v_mfma_f32_32x32x16_bf16 v[64:79], v[112:115], v[120:123], v[64:79]
    s_waitcnt lgkmcnt(6)
    v_mfma_f32_32x32x16_bf16 v[96:111], v[124:127], v[120:123], v[96:111]
    v_mfma_f32_32x32x16_bf16 v[80:95], v[124:127], v[116:119], v[80:95]
    s_waitcnt lgkmcnt(0)
    s_barrier
    ds_read_b64_tr_b16 v[112:113], v26 offset:32768
    ds_read_b64_tr_b16 v[114:115], v26 offset:33792
    ds_read_b128 v[116:119], v22 offset:32768
    v_mfma_f32_32x32x16_bf16 v[48:63], v[136:139], v[140:143], v[48:63]
    ds_read_b128 v[120:123], v22 offset:36864
    ds_read_b64_tr_b16 v[124:125], v27 offset:32768
    ds_read_b64_tr_b16 v[126:127], v27 offset:33792
    v_mfma_f32_32x32x16_bf16 v[64:79], v[136:139], v[144:147], v[64:79]
    v_mfma_f32_32x32x16_bf16 v[96:111], v[148:151], v[144:147], v[96:111]
    v_mfma_f32_32x32x16_bf16 v[80:95], v[148:151], v[140:143], v[80:95]
    s_waitcnt lgkmcnt(3)
    ds_read_b64_tr_b16 v[136:137], v26 offset:36864
    ds_read_b64_tr_b16 v[138:139], v26 offset:37888
    ds_read_b128 v[140:143], v23 offset:32768
    v_mfma_f32_32x32x16_bf16 v[48:63], v[112:115], v[116:119], v[48:63]
    ds_read_b128 v[144:147], v23 offset:36864
    ds_read_b64_tr_b16 v[148:149], v27 offset:36864
    ds_read_b64_tr_b16 v[150:151], v27 offset:37888
    s_waitcnt lgkmcnt(8)
    v_mfma_f32_32x32x16_bf16 v[64:79], v[112:115], v[120:123], v[64:79]
    s_waitcnt lgkmcnt(6)
    v_mfma_f32_32x32x16_bf16 v[96:111], v[124:127], v[120:123], v[96:111]
    v_mfma_f32_32x32x16_bf16 v[80:95], v[124:127], v[116:119], v[80:95]
    s_waitcnt lgkmcnt(3)
    ds_read_b64_tr_b16 v[112:113], v26 offset:40960
    ds_read_b64_tr_b16 v[114:115], v26 offset:41984
    ds_read_b128 v[116:119], v24 offset:32768
    v_mfma_f32_32x32x16_bf16 v[48:63], v[136:139], v[140:143], v[48:63]
    ds_read_b128 v[120:123], v24 offset:36864
    ds_read_b64_tr_b16 v[124:125], v27 offset:40960
    ds_read_b64_tr_b16 v[126:127], v27 offset:41984
    s_waitcnt lgkmcnt(8)
    v_mfma_f32_32x32x16_bf16 v[64:79], v[136:139], v[144:147], v[64:79]
    s_waitcnt lgkmcnt(6)
    v_mfma_f32_32x32x16_bf16 v[96:111], v[148:151], v[144:147], v[96:111]
    v_mfma_f32_32x32x16_bf16 v[80:95], v[148:151], v[140:143], v[80:95]
    s_waitcnt lgkmcnt(3)
    ds_read_b64_tr_b16 v[136:137], v26 offset:45056
    ds_read_b64_tr_b16 v[138:139], v26 offset:46080
    ds_read_b128 v[140:143], v25 offset:32768
    v_mfma_f32_32x32x16_bf16 v[48:63], v[112:115], v[116:119], v[48:63]
    ds_read_b128 v[144:147], v25 offset:36864
    ds_read_b64_tr_b16 v[148:149], v27 offset:45056
    ds_read_b64_tr_b16 v[150:151], v27 offset:46080
    s_waitcnt lgkmcnt(8)
    v_mfma_f32_32x32x16_bf16 v[64:79], v[112:115], v[120:123], v[64:79]
    s_waitcnt lgkmcnt(6)
    v_mfma_f32_32x32x16_bf16 v[96:111], v[124:127], v[120:123], v[96:111]
    v_mfma_f32_32x32x16_bf16 v[80:95], v[124:127], v[116:119], v[80:95]
    s_waitcnt lgkmcnt(0)
    s_barrier
    v_add_u32 v26, 0x10000, v26
    v_add_u32 v22, 0x10000, v22
    v_add_u32 v27, 0x10000, v27
    ds_read_b64_tr_b16 v[112:113], v26 offset:0
    ds_read_b64_tr_b16 v[114:115], v26 offset:1024
    ds_read_b128 v[116:119], v22 offset:0
    v_mfma_f32_32x32x16_bf16 v[48:63], v[136:139], v[140:143], v[48:63]
    ds_read_b128 v[120:123], v22 offset:4096
    ds_read_b64_tr_b16 v[124:125], v27 offset:0
    ds_read_b64_tr_b16 v[126:127], v27 offset:1024
    v_mfma_f32_32x32x16_bf16 v[64:79], v[136:139], v[144:147], v[64:79]
    v_mfma_f32_32x32x16_bf16 v[96:111], v[148:151], v[144:147], v[96:111]
    v_mfma_f32_32x32x16_bf16 v[80:95], v[148:151], v[140:143], v[80:95]
    v_add_u32 v23, 0x10000, v23
    global_load_dword v32, v36, s[12:13] sc1
    s_waitcnt lgkmcnt(3)
    ds_read_b64_tr_b16 v[136:137], v26 offset:4096
    ds_read_b64_tr_b16 v[138:139], v26 offset:5120
    ds_read_b128 v[140:143], v23 offset:0
    v_mfma_f32_32x32x16_bf16 v[48:63], v[112:115], v[116:119], v[48:63]
    ds_read_b128 v[144:147], v23 offset:4096
    ds_read_b64_tr_b16 v[148:149], v27 offset:4096
    ds_read_b64_tr_b16 v[150:151], v27 offset:5120
    s_waitcnt lgkmcnt(8)
    v_mfma_f32_32x32x16_bf16 v[64:79], v[112:115], v[120:123], v[64:79]
    s_waitcnt lgkmcnt(6)
    v_mfma_f32_32x32x16_bf16 v[96:111], v[124:127], v[120:123], v[96:111]
    v_mfma_f32_32x32x16_bf16 v[80:95], v[124:127], v[116:119], v[80:95]
    v_add_u32 v24, 0x10000, v24
    s_waitcnt lgkmcnt(3)
    ds_read_b64_tr_b16 v[112:113], v26 offset:8192
    ds_read_b64_tr_b16 v[114:115], v26 offset:9216
    ds_read_b128 v[116:119], v24 offset:0
    v_mfma_f32_32x32x16_bf16 v[48:63], v[136:139], v[140:143], v[48:63]
    ds_read_b128 v[120:123], v24 offset:4096
    ds_read_b64_tr_b16 v[124:125], v27 offset:8192
    ds_read_b64_tr_b16 v[126:127], v27 offset:9216
    s_waitcnt lgkmcnt(8)
    v_mfma_f32_32x32x16_bf16 v[64:79], v[136:139], v[144:147], v[64:79]
    s_waitcnt lgkmcnt(6)
    v_mfma_f32_32x32x16_bf16 v[96:111], v[148:151], v[144:147], v[96:111]
    v_mfma_f32_32x32x16_bf16 v[80:95], v[148:151], v[140:143], v[80:95]
    v_add_u32 v25, 0x10000, v25
    s_waitcnt lgkmcnt(3)
    ds_read_b64_tr_b16 v[136:137], v26 offset:12288
    ds_read_b64_tr_b16 v[138:139], v26 offset:13312
    ds_read_b128 v[140:143], v25 offset:0
    v_mfma_f32_32x32x16_bf16 v[48:63], v[112:115], v[116:119], v[48:63]
    ds_read_b128 v[144:147], v25 offset:4096
    ds_read_b64_tr_b16 v[148:149], v27 offset:12288
    ds_read_b64_tr_b16 v[150:151], v27 offset:13312
    s_waitcnt lgkmcnt(8)
    v_mfma_f32_32x32x16_bf16 v[64:79], v[112:115], v[120:123], v[64:79]
    s_waitcnt lgkmcnt(6)
    v_mfma_f32_32x32x16_bf16 v[96:111], v[124:127], v[120:123], v[96:111]
    v_mfma_f32_32x32x16_bf16 v[80:95], v[124:127], v[116:119], v[80:95]
    s_waitcnt lgkmcnt(0)
    s_barrier
    ds_read_b64_tr_b16 v[112:113], v26 offset:32768
    ds_read_b64_tr_b16 v[114:115], v26 offset:33792
    ds_read_b128 v[116:119], v22 offset:32768
    v_mfma_f32_32x32x16_bf16 v[48:63], v[136:139], v[140:143], v[48:63]
    ds_read_b128 v[120:123], v22 offset:36864
    ds_read_b64_tr_b16 v[124:125], v27 offset:32768
    ds_read_b64_tr_b16 v[126:127], v27 offset:33792
    v_mfma_f32_32x32x16_bf16 v[64:79], v[136:139], v[144:147], v[64:79]
    v_mfma_f32_32x32x16_bf16 v[96:111], v[148:151], v[144:147], v[96:111]
    v_mfma_f32_32x32x16_bf16 v[80:95], v[148:151], v[140:143], v[80:95]
    s_waitcnt lgkmcnt(3)
    ds_read_b64_tr_b16 v[136:137], v26 offset:36864
    ds_read_b64_tr_b16 v[138:139], v26 offset:37888
    ds_read_b128 v[140:143], v23 offset:32768
    v_mfma_f32_32x32x16_bf16 v[48:63], v[112:115], v[116:119], v[48:63]
    ds_read_b128 v[144:147], v23 offset:36864
    ds_read_b64_tr_b16 v[148:149], v27 offset:36864
    ds_read_b64_tr_b16 v[150:151], v27 offset:37888
    s_waitcnt lgkmcnt(8)
    v_mfma_f32_32x32x16_bf16 v[64:79], v[112:115], v[120:123], v[64:79]
    s_waitcnt lgkmcnt(6)
    v_mfma_f32_32x32x16_bf16 v[96:111], v[124:127], v[120:123], v[96:111]
    v_mfma_f32_32x32x16_bf16 v[80:95], v[124:127], v[116:119], v[80:95]
    s_waitcnt lgkmcnt(3)
    ds_read_b64_tr_b16 v[112:113], v26 offset:40960
    ds_read_b64_tr_b16 v[114:115], v26 offset:41984
    ds_read_b128 v[116:119], v24 offset:32768
    v_mfma_f32_32x32x16_bf16 v[48:63], v[136:139], v[140:143], v[48:63]
    ds_read_b128 v[120:123], v24 offset:36864
    ds_read_b64_tr_b16 v[124:125], v27 offset:40960
    ds_read_b64_tr_b16 v[126:127], v27 offset:41984
    s_waitcnt lgkmcnt(8)
    v_mfma_f32_32x32x16_bf16 v[64:79], v[136:139], v[144:147], v[64:79]
    s_waitcnt lgkmcnt(6)
    v_mfma_f32_32x32x16_bf16 v[96:111], v[148:151], v[144:147], v[96:111]
    v_mfma_f32_32x32x16_bf16 v[80:95], v[148:151], v[140:143], v[80:95]
    s_waitcnt lgkmcnt(3)
    ds_read_b64_tr_b16 v[136:137], v26 offset:45056
    ds_read_b64_tr_b16 v[138:139], v26 offset:46080
    ds_read_b128 v[140:143], v25 offset:32768
    v_mfma_f32_32x32x16_bf16 v[48:63], v[112:115], v[116:119], v[48:63]
    ds_read_b128 v[144:147], v25 offset:36864
    ds_read_b64_tr_b16 v[148:149], v27 offset:45056
    ds_read_b64_tr_b16 v[150:151], v27 offset:46080
    s_waitcnt lgkmcnt(8)
    v_mfma_f32_32x32x16_bf16 v[64:79], v[112:115], v[120:123], v[64:79]
    s_waitcnt lgkmcnt(6)
    v_mfma_f32_32x32x16_bf16 v[96:111], v[124:127], v[120:123], v[96:111]
    v_mfma_f32_32x32x16_bf16 v[80:95], v[124:127], v[116:119], v[80:95]
    s_waitcnt lgkmcnt(0)
    s_barrier
    v_add_u32 v26, 0x10000, v26
    v_add_u32 v22, 0x10000, v22
    v_add_u32 v23, 0x10000, v23
    ds_read_b64_tr_b16 v[112:113], v26 offset:0
    ds_read_b64_tr_b16 v[114:115], v26 offset:1024
    ds_read_b128 v[116:119], v22 offset:0
    v_mfma_f32_32x32x16_bf16 v[48:63], v[136:139], v[140:143], v[48:63]
    ds_read_b128 v[120:123], v22 offset:4096
    ds_read_b64_tr_b16 v[124:125], v26 offset:4096
    ds_read_b64_tr_b16 v[126:127], v26 offset:5120
    v_mfma_f32_32x32x16_bf16 v[64:79], v[136:139], v[144:147], v[64:79]
    ds_read_b128 v[128:131], v23 offset:0
    ds_read_b128 v[132:135], v23 offset:4096
    v_mfma_f32_32x32x16_bf16 v[96:111], v[148:151], v[144:147], v[96:111]
    v_mfma_f32_32x32x16_bf16 v[80:95], v[148:151], v[140:143], v[80:95]
    v_add_u32 v24, 0x10000, v24
    v_add_u32 v25, 0x10000, v25
    s_waitcnt lgkmcnt(5)
    ds_read_b64_tr_b16 v[136:137], v26 offset:8192
    ds_read_b64_tr_b16 v[138:139], v26 offset:9216
    ds_read_b128 v[140:143], v24 offset:0
    v_mfma_f32_32x32x16_bf16 v[48:63], v[112:115], v[116:119], v[48:63]
    ds_read_b128 v[144:147], v24 offset:4096
    ds_read_b64_tr_b16 v[148:149], v26 offset:12288
    ds_read_b64_tr_b16 v[150:151], v26 offset:13312
    s_waitcnt lgkmcnt(10)
    v_mfma_f32_32x32x16_bf16 v[64:79], v[112:115], v[120:123], v[64:79]
    ds_read_b128 v[152:155], v25 offset:0
    ds_read_b128 v[156:159], v25 offset:4096
    s_waitcnt lgkmcnt(9)
    v_mfma_f32_32x32x16_bf16 v[48:63], v[124:127], v[128:131], v[48:63]
    s_waitcnt lgkmcnt(8)
    v_mfma_f32_32x32x16_bf16 v[64:79], v[124:127], v[132:135], v[64:79]
    s_waitcnt lgkmcnt(0)
    s_barrier
    v_add_u32 v26, 0xfffe0000, v26
    v_add_u32 v22, 0xfffe0000, v22
    v_add_u32 v23, 0xfffe0000, v23
    ds_read_b64_tr_b16 v[112:113], v26 offset:0
    ds_read_b64_tr_b16 v[114:115], v26 offset:1024
    ds_read_b128 v[116:119], v22 offset:0
    v_mfma_f32_32x32x16_bf16 v[48:63], v[136:139], v[140:143], v[48:63]
    ds_read_b128 v[120:123], v22 offset:4096
    ds_read_b64_tr_b16 v[124:125], v26 offset:4096
    ds_read_b64_tr_b16 v[126:127], v26 offset:5120
    v_mfma_f32_32x32x16_bf16 v[64:79], v[136:139], v[144:147], v[64:79]
    ds_read_b128 v[128:131], v23 offset:0
    ds_read_b128 v[132:135], v23 offset:4096
    v_mfma_f32_32x32x16_bf16 v[48:63], v[148:151], v[152:155], v[48:63]
    v_mfma_f32_32x32x16_bf16 v[64:79], v[148:151], v[156:159], v[64:79]
    v_add_u32 v24, 0xfffe0000, v24
    v_add_u32 v25, 0xfffe0000, v25
    s_waitcnt lgkmcnt(5)
    ds_read_b64_tr_b16 v[136:137], v26 offset:8192
    ds_read_b64_tr_b16 v[138:139], v26 offset:9216
    ds_read_b128 v[140:143], v24 offset:0
    v_mfma_f32_32x32x16_bf16 v[48:63], v[112:115], v[116:119], v[48:63]
    ds_read_b128 v[144:147], v24 offset:4096
    ds_read_b64_tr_b16 v[148:149], v26 offset:12288
    ds_read_b64_tr_b16 v[150:151], v26 offset:13312
    s_waitcnt lgkmcnt(10)
    v_mfma_f32_32x32x16_bf16 v[64:79], v[112:115], v[120:123], v[64:79]
    ds_read_b128 v[152:155], v25 offset:0
    ds_read_b128 v[156:159], v25 offset:4096
    s_waitcnt lgkmcnt(9)
    v_mfma_f32_32x32x16_bf16 v[48:63], v[124:127], v[128:131], v[48:63]
    s_waitcnt lgkmcnt(8)
    v_mfma_f32_32x32x16_bf16 v[64:79], v[124:127], v[132:135], v[64:79]
    s_waitcnt lgkmcnt(0)
    s_barrier
    ds_read_b64_tr_b16 v[112:113], v26 offset:32768
    ds_read_b64_tr_b16 v[114:115], v26 offset:33792
    ds_read_b128 v[116:119], v22 offset:32768
    v_mfma_f32_32x32x16_bf16 v[48:63], v[136:139], v[140:143], v[48:63]
    ds_read_b128 v[120:123], v22 offset:36864
    ds_read_b64_tr_b16 v[124:125], v26 offset:36864
    ds_read_b64_tr_b16 v[126:127], v26 offset:37888
    v_mfma_f32_32x32x16_bf16 v[64:79], v[136:139], v[144:147], v[64:79]
    ds_read_b128 v[128:131], v23 offset:32768
    ds_read_b128 v[132:135], v23 offset:36864
    v_mfma_f32_32x32x16_bf16 v[48:63], v[148:151], v[152:155], v[48:63]
    v_mfma_f32_32x32x16_bf16 v[64:79], v[148:151], v[156:159], v[64:79]
    s_waitcnt lgkmcnt(5)
    ds_read_b64_tr_b16 v[136:137], v26 offset:40960
    ds_read_b64_tr_b16 v[138:139], v26 offset:41984
    ds_read_b128 v[140:143], v24 offset:32768
    v_mfma_f32_32x32x16_bf16 v[48:63], v[112:115], v[116:119], v[48:63]
    ds_read_b128 v[144:147], v24 offset:36864
    ds_read_b64_tr_b16 v[148:149], v26 offset:45056
    ds_read_b64_tr_b16 v[150:151], v26 offset:46080
    s_waitcnt lgkmcnt(10)
    v_mfma_f32_32x32x16_bf16 v[64:79], v[112:115], v[120:123], v[64:79]
    ds_read_b128 v[152:155], v25 offset:32768
    ds_read_b128 v[156:159], v25 offset:36864
    s_waitcnt lgkmcnt(9)
    v_mfma_f32_32x32x16_bf16 v[48:63], v[124:127], v[128:131], v[48:63]
    s_waitcnt lgkmcnt(8)
    v_mfma_f32_32x32x16_bf16 v[64:79], v[124:127], v[132:135], v[64:79]
    v_add_u32 v27, 0x10000, v27
    v_add_u32 v22, 0x20000, v22
    v_add_u32 v23, 0x20000, v23
    s_waitcnt lgkmcnt(5)
    ds_read_b64_tr_b16 v[112:113], v27 offset:0
    ds_read_b64_tr_b16 v[114:115], v27 offset:1024
    ds_read_b128 v[116:119], v22 offset:0
    v_mfma_f32_32x32x16_bf16 v[48:63], v[136:139], v[140:143], v[48:63]
    ds_read_b128 v[120:123], v22 offset:4096
    ds_read_b64_tr_b16 v[124:125], v27 offset:4096
    ds_read_b64_tr_b16 v[126:127], v27 offset:5120
    s_waitcnt lgkmcnt(10)
    v_mfma_f32_32x32x16_bf16 v[64:79], v[136:139], v[144:147], v[64:79]
    ds_read_b128 v[128:131], v23 offset:0
    ds_read_b128 v[132:135], v23 offset:4096
    s_waitcnt lgkmcnt(9)
    v_mfma_f32_32x32x16_bf16 v[48:63], v[148:151], v[152:155], v[48:63]
    s_waitcnt lgkmcnt(8)
    v_mfma_f32_32x32x16_bf16 v[64:79], v[148:151], v[156:159], v[64:79]
    v_add_u32 v24, 0x20000, v24
    v_add_u32 v25, 0x20000, v25
    s_waitcnt lgkmcnt(5)
    ds_read_b64_tr_b16 v[136:137], v27 offset:8192
    ds_read_b64_tr_b16 v[138:139], v27 offset:9216
    ds_read_b128 v[140:143], v24 offset:0
    v_mfma_f32_32x32x16_bf16 v[80:95], v[112:115], v[116:119], v[80:95]
    ds_read_b128 v[144:147], v24 offset:4096
    ds_read_b64_tr_b16 v[148:149], v27 offset:12288
    ds_read_b64_tr_b16 v[150:151], v27 offset:13312
    s_waitcnt lgkmcnt(10)
    v_mfma_f32_32x32x16_bf16 v[96:111], v[112:115], v[120:123], v[96:111]
    ds_read_b128 v[152:155], v25 offset:0
    ds_read_b128 v[156:159], v25 offset:4096
    s_waitcnt lgkmcnt(9)
    v_mfma_f32_32x32x16_bf16 v[80:95], v[124:127], v[128:131], v[80:95]
    s_waitcnt lgkmcnt(8)
    v_mfma_f32_32x32x16_bf16 v[96:111], v[124:127], v[132:135], v[96:111]
    v_add_u32 v27, 0xfffe0000, v27
    v_add_u32 v22, 0xfffe0000, v22
    v_add_u32 v23, 0xfffe0000, v23
    s_waitcnt lgkmcnt(5)
    ds_read_b64_tr_b16 v[112:113], v27 offset:0
    ds_read_b64_tr_b16 v[114:115], v27 offset:1024
    ds_read_b128 v[116:119], v22 offset:0
    v_mfma_f32_32x32x16_bf16 v[80:95], v[136:139], v[140:143], v[80:95]
    ds_read_b128 v[120:123], v22 offset:4096
    ds_read_b64_tr_b16 v[124:125], v27 offset:4096
    ds_read_b64_tr_b16 v[126:127], v27 offset:5120
    v_cvt_pk_bf16_f32 v160, v48, v49
    v_cvt_pk_bf16_f32 v161, v50, v51
    s_waitcnt lgkmcnt(10)
    v_mfma_f32_32x32x16_bf16 v[96:111], v[136:139], v[144:147], v[96:111]
    ds_read_b128 v[128:131], v23 offset:0
    ds_read_b128 v[132:135], v23 offset:4096
    v_cvt_pk_bf16_f32 v162, v52, v53
    v_cvt_pk_bf16_f32 v163, v54, v55
    v_pk_max_i16 v160, v160, 0
    v_pk_max_i16 v161, v161, 0
    v_pk_max_i16 v162, v162, 0
    s_waitcnt lgkmcnt(9)
    v_mfma_f32_32x32x16_bf16 v[80:95], v[148:151], v[152:155], v[80:95]
    v_pk_max_i16 v163, v163, 0
    buffer_store_dwordx4 v[160:163], v30, s[28:31], s54 offen sc1
    v_cvt_pk_bf16_f32 v164, v56, v57
    v_cvt_pk_bf16_f32 v165, v58, v59
    v_cvt_pk_bf16_f32 v166, v60, v61
    s_waitcnt lgkmcnt(8)
    v_mfma_f32_32x32x16_bf16 v[96:111], v[148:151], v[156:159], v[96:111]
    v_cvt_pk_bf16_f32 v167, v62, v63
    v_pk_max_i16 v164, v164, 0
    v_pk_max_i16 v165, v165, 0
    v_pk_max_i16 v166, v166, 0
    v_pk_max_i16 v167, v167, 0
    v_add_u32 v24, 0xfffe0000, v24
    v_add_u32 v25, 0xfffe0000, v25
    s_waitcnt lgkmcnt(5)
    ds_read_b64_tr_b16 v[136:137], v27 offset:8192
    ds_read_b64_tr_b16 v[138:139], v27 offset:9216
    ds_read_b128 v[140:143], v24 offset:0
    v_mfma_f32_32x32x16_bf16 v[80:95], v[112:115], v[116:119], v[80:95]
    ds_read_b128 v[144:147], v24 offset:4096
    ds_read_b64_tr_b16 v[148:149], v27 offset:12288
    ds_read_b64_tr_b16 v[150:151], v27 offset:13312
    buffer_store_dwordx4 v[164:167], v30, s[28:31], s54 offen offset:2048 sc1
    v_cvt_pk_bf16_f32 v168, v64, v65
    s_waitcnt lgkmcnt(10)
    v_mfma_f32_32x32x16_bf16 v[96:111], v[112:115], v[120:123], v[96:111]
    ds_read_b128 v[152:155], v25 offset:0
    ds_read_b128 v[156:159], v25 offset:4096
    v_cvt_pk_bf16_f32 v169, v66, v67
    v_cvt_pk_bf16_f32 v170, v68, v69
    v_cvt_pk_bf16_f32 v171, v70, v71
    v_pk_max_i16 v168, v168, 0
    v_pk_max_i16 v169, v169, 0
    s_waitcnt lgkmcnt(9)
    v_mfma_f32_32x32x16_bf16 v[80:95], v[124:127], v[128:131], v[80:95]
    v_pk_max_i16 v170, v170, 0
    v_pk_max_i16 v171, v171, 0
    buffer_store_dwordx4 v[168:171], v30, s[28:31], s54 offen offset:1024 sc1
    v_cvt_pk_bf16_f32 v172, v72, v73
    v_cvt_pk_bf16_f32 v173, v74, v75
    s_waitcnt lgkmcnt(8)
    v_mfma_f32_32x32x16_bf16 v[96:111], v[124:127], v[132:135], v[96:111]
    v_cvt_pk_bf16_f32 v174, v76, v77
    v_cvt_pk_bf16_f32 v175, v78, v79
    v_pk_max_i16 v172, v172, 0
    v_pk_max_i16 v173, v173, 0
    v_pk_max_i16 v174, v174, 0
    s_waitcnt lgkmcnt(5)
    ds_read_b64_tr_b16 v[112:113], v27 offset:32768
    ds_read_b64_tr_b16 v[114:115], v27 offset:33792
    ds_read_b128 v[116:119], v22 offset:32768
    v_mfma_f32_32x32x16_bf16 v[80:95], v[136:139], v[140:143], v[80:95]
    ds_read_b128 v[120:123], v22 offset:36864
    ds_read_b64_tr_b16 v[124:125], v27 offset:36864
    ds_read_b64_tr_b16 v[126:127], v27 offset:37888
    v_pk_max_i16 v175, v175, 0
    buffer_store_dwordx4 v[172:175], v30, s[28:31], s54 offen offset:3072 sc1
    s_waitcnt lgkmcnt(10)
    v_mfma_f32_32x32x16_bf16 v[96:111], v[136:139], v[144:147], v[96:111]
    ds_read_b128 v[128:131], v23 offset:32768
    ds_read_b128 v[132:135], v23 offset:36864
    s_waitcnt lgkmcnt(9)
    v_mfma_f32_32x32x16_bf16 v[80:95], v[148:151], v[152:155], v[80:95]
    s_waitcnt lgkmcnt(8)
    v_mfma_f32_32x32x16_bf16 v[96:111], v[148:151], v[156:159], v[96:111]
    s_waitcnt lgkmcnt(5)
    ds_read_b64_tr_b16 v[136:137], v27 offset:40960
    ds_read_b64_tr_b16 v[138:139], v27 offset:41984
    ds_read_b128 v[140:143], v24 offset:32768
    v_mfma_f32_32x32x16_bf16 v[80:95], v[112:115], v[116:119], v[80:95]
    ds_read_b128 v[144:147], v24 offset:36864
    ds_read_b64_tr_b16 v[148:149], v27 offset:45056
    ds_read_b64_tr_b16 v[150:151], v27 offset:46080
    s_waitcnt lgkmcnt(10)
    v_mfma_f32_32x32x16_bf16 v[96:111], v[112:115], v[120:123], v[96:111]
    ds_read_b128 v[152:155], v25 offset:32768
    ds_read_b128 v[156:159], v25 offset:36864
    s_waitcnt lgkmcnt(9)
    v_mfma_f32_32x32x16_bf16 v[80:95], v[124:127], v[128:131], v[80:95]
    s_waitcnt lgkmcnt(8)
    v_mfma_f32_32x32x16_bf16 v[96:111], v[124:127], v[132:135], v[96:111]
    s_waitcnt lgkmcnt(5)
    v_mfma_f32_32x32x16_bf16 v[80:95], v[136:139], v[140:143], v[80:95]
    s_waitcnt lgkmcnt(4)
    v_mfma_f32_32x32x16_bf16 v[96:111], v[136:139], v[144:147], v[96:111]
    s_waitcnt lgkmcnt(1)
    v_mfma_f32_32x32x16_bf16 v[80:95], v[148:151], v[152:155], v[80:95]
    s_waitcnt lgkmcnt(0)
    v_mfma_f32_32x32x16_bf16 v[96:111], v[148:151], v[156:159], v[96:111]
    s_nop 10
    v_cvt_pk_bf16_f32 v176, v80, v81
    v_cvt_pk_bf16_f32 v177, v82, v83
    v_cvt_pk_bf16_f32 v178, v84, v85
    v_cvt_pk_bf16_f32 v179, v86, v87
    v_pk_max_i16 v176, v176, 0
    v_pk_max_i16 v177, v177, 0
    v_pk_max_i16 v178, v178, 0
    v_pk_max_i16 v179, v179, 0
    buffer_store_dwordx4 v[176:179], v30, s[28:31], s98 offen sc1
    v_cvt_pk_bf16_f32 v180, v88, v89
    v_cvt_pk_bf16_f32 v181, v90, v91
    v_cvt_pk_bf16_f32 v182, v92, v93
    v_cvt_pk_bf16_f32 v183, v94, v95
    v_pk_max_i16 v180, v180, 0
    v_pk_max_i16 v181, v181, 0
    v_pk_max_i16 v182, v182, 0
    v_pk_max_i16 v183, v183, 0
    buffer_store_dwordx4 v[180:183], v30, s[28:31], s98 offen offset:2048 sc1
    v_cvt_pk_bf16_f32 v184, v96, v97
    v_cvt_pk_bf16_f32 v185, v98, v99
    v_cvt_pk_bf16_f32 v186, v100, v101
    v_cvt_pk_bf16_f32 v187, v102, v103
    v_pk_max_i16 v184, v184, 0
    v_pk_max_i16 v185, v185, 0
    v_pk_max_i16 v186, v186, 0
    v_pk_max_i16 v187, v187, 0
    buffer_store_dwordx4 v[184:187], v30, s[28:31], s98 offen offset:1024 sc1
    v_cvt_pk_bf16_f32 v188, v104, v105
    v_cvt_pk_bf16_f32 v189, v106, v107
    v_cvt_pk_bf16_f32 v190, v108, v109
    v_cvt_pk_bf16_f32 v191, v110, v111
    v_pk_max_i16 v188, v188, 0
    v_pk_max_i16 v189, v189, 0
    v_pk_max_i16 v190, v190, 0
    v_pk_max_i16 v191, v191, 0
    buffer_store_dwordx4 v[188:191], v30, s[28:31], s98 offen offset:3072 sc1
    s_barrier
    s_bfe_u32 s49, s48, 0x30008
    s_mul_i32 s49, s49, 57344
    s_add_u32 m0, s51, 131072
    s_add_u32 s50, s49, 28672
    buffer_load_dwordx4 v18, s[24:27], s49 offen lds
    buffer_load_dwordx4 v19, s[24:27], s49 offen offset:1024 lds
    buffer_load_dwordx4 v20, s[24:27], s49 offen offset:2048 lds
    buffer_load_dwordx4 v21, s[24:27], s49 offen offset:3072 lds
    s_add_u32 m0, s51, 135168
    s_nop 0
    buffer_load_dwordx4 v18, s[24:27], s50 offen lds
    buffer_load_dwordx4 v19, s[24:27], s50 offen offset:1024 lds
    buffer_load_dwordx4 v20, s[24:27], s50 offen offset:2048 lds
    buffer_load_dwordx4 v21, s[24:27], s50 offen offset:3072 lds
    ds_read_b64_tr_b16 v[192:193], v40 offset:0
    ds_read_b64_tr_b16 v[194:195], v40 offset:1024
    ds_read_b64_tr_b16 v[196:197], v41 offset:0
    ds_read_b64_tr_b16 v[198:199], v41 offset:1024
    ds_read_b64_tr_b16 v[200:201], v40 offset:2048
    ds_read_b64_tr_b16 v[202:203], v40 offset:3072
    ds_read_b64_tr_b16 v[204:205], v41 offset:2048
    ds_read_b64_tr_b16 v[206:207], v41 offset:3072
    ds_read_b64_tr_b16 v[208:209], v40 offset:4096
    ds_read_b64_tr_b16 v[210:211], v40 offset:5120
    ds_read_b64_tr_b16 v[212:213], v41 offset:4096
    ds_read_b64_tr_b16 v[214:215], v41 offset:5120
    ds_read_b64_tr_b16 v[216:217], v40 offset:6144
    ds_read_b64_tr_b16 v[218:219], v40 offset:7168
    ds_read_b64_tr_b16 v[220:221], v41 offset:6144
    ds_read_b64_tr_b16 v[222:223], v41 offset:7168
    ds_read_b64_tr_b16 v[224:225], v40 offset:32768
    ds_read_b64_tr_b16 v[226:227], v40 offset:33792
    ds_read_b64_tr_b16 v[228:229], v41 offset:32768
    ds_read_b64_tr_b16 v[230:231], v41 offset:33792
    ds_read_b64_tr_b16 v[232:233], v40 offset:34816
    ds_read_b64_tr_b16 v[234:235], v40 offset:35840
    ds_read_b64_tr_b16 v[236:237], v41 offset:34816
    ds_read_b64_tr_b16 v[238:239], v41 offset:35840
    ds_read_b64_tr_b16 v[240:241], v40 offset:36864
    ds_read_b64_tr_b16 v[242:243], v40 offset:37888
    ds_read_b64_tr_b16 v[244:245], v41 offset:36864
    ds_read_b64_tr_b16 v[246:247], v41 offset:37888
    ds_read_b64_tr_b16 v[248:249], v40 offset:38912
    ds_read_b64_tr_b16 v[250:251], v40 offset:39936
    ds_read_b64_tr_b16 v[252:253], v41 offset:38912
    ds_read_b64_tr_b16 v[254:255], v41 offset:39936
    s_waitcnt vmcnt(16)
    v_cmp_ne_u32 vcc, 0, v32
    s_cbranch_vccnz L_epoch_ok
    s_mov_b32 s44, 0
L_epoch_spin:
    global_load_dword v32, v36, s[12:13] sc1
    s_waitcnt vmcnt(0)
    s_add_u32 s44, s44, 1
    s_cmp_ge_u32 s44, 0x40000
    s_cbranch_scc1 L_epoch_ok
    v_cmp_eq_u32 vcc, 0, v32
    s_cbranch_vccnz L_epoch_spin
L_epoch_ok:
    v_readfirstlane_b32 s60, v32
    v_readfirstlane_b32 s61, v32
    s_nop 4
    s_waitcnt vmcnt(8)
    s_atomic_swap s60, s[4:5], 0
    s_bfe_u32 s49, s48, 0x3000c
    s_mul_i32 s49, s49, 57344
    s_add_u32 m0, s51, 0
    s_add_u32 s50, s49, 28672
    buffer_load_dwordx4 v18, s[24:27], s49 offen lds
    buffer_load_dwordx4 v19, s[24:27], s49 offen offset:1024 lds
    buffer_load_dwordx4 v20, s[24:27], s49 offen offset:2048 lds
    buffer_load_dwordx4 v21, s[24:27], s49 offen offset:3072 lds
    s_add_u32 m0, s51, 4096
    s_nop 0
    buffer_load_dwordx4 v18, s[24:27], s50 offen lds
    buffer_load_dwordx4 v19, s[24:27], s50 offen offset:1024 lds
    buffer_load_dwordx4 v20, s[24:27], s50 offen offset:2048 lds
    buffer_load_dwordx4 v21, s[24:27], s50 offen offset:3072 lds
    s_bfe_u32 s49, s48, 0x30010
    s_mul_i32 s49, s49, 57344
    s_add_u32 m0, s51, 32768
    s_add_u32 s50, s49, 28672
    buffer_load_dwordx4 v18, s[24:27], s49 offen lds
    buffer_load_dwordx4 v19, s[24:27], s49 offen offset:1024 lds
    buffer_load_dwordx4 v20, s[24:27], s49 offen offset:2048 lds
    buffer_load_dwordx4 v21, s[24:27], s49 offen offset:3072 lds
    s_add_u32 m0, s51, 36864
    s_nop 0
    buffer_load_dwordx4 v18, s[24:27], s50 offen lds
    buffer_load_dwordx4 v19, s[24:27], s50 offen offset:1024 lds
    buffer_load_dwordx4 v20, s[24:27], s50 offen offset:2048 lds
    buffer_load_dwordx4 v21, s[24:27], s50 offen offset:3072 lds
    s_waitcnt lgkmcnt(15)
    s_bfe_u32 s49, s48, 0x30014
    s_mul_i32 s49, s49, 57344
    s_add_u32 m0, s51, 65536
    s_add_u32 s50, s49, 28672
    buffer_load_dwordx4 v18, s[24:27], s49 offen lds
    buffer_load_dwordx4 v19, s[24:27], s49 offen offset:1024 lds
    buffer_load_dwordx4 v20, s[24:27], s49 offen offset:2048 lds
    buffer_load_dwordx4 v21, s[24:27], s49 offen offset:3072 lds
    s_add_u32 m0, s51, 69632
    s_nop 0
    buffer_load_dwordx4 v18, s[24:27], s50 offen lds
    buffer_load_dwordx4 v19, s[24:27], s50 offen offset:1024 lds
    buffer_load_dwordx4 v20, s[24:27], s50 offen offset:2048 lds
    buffer_load_dwordx4 v21, s[24:27], s50 offen offset:3072 lds
    s_waitcnt lgkmcnt(0)
    s_load_dwordx8 s[16:23], s[6:7], 0 glc
    s_bfe_u32 s49, s48, 0x30018
    s_mul_i32 s49, s49, 57344
    s_add_u32 m0, s51, 98304
    s_add_u32 s50, s49, 28672
    buffer_load_dwordx4 v18, s[24:27], s49 offen lds
    buffer_load_dwordx4 v19, s[24:27], s49 offen offset:1024 lds
    buffer_load_dwordx4 v20, s[24:27], s49 offen offset:2048 lds
    buffer_load_dwordx4 v21, s[24:27], s49 offen offset:3072 lds
    s_add_u32 m0, s51, 102400
    s_nop 0
    buffer_load_dwordx4 v18, s[24:27], s50 offen lds
    buffer_load_dwordx4 v19, s[24:27], s50 offen offset:1024 lds
    buffer_load_dwordx4 v20, s[24:27], s50 offen offset:2048 lds
    buffer_load_dwordx4 v21, s[24:27], s50 offen offset:3072 lds
    s_mov_b32 s44, 0
    s_branch L_poll_chk
L_poll:
    s_load_dwordx8 s[16:23], s[6:7], 0 glc
    s_add_u32 s44, s44, 1
    s_cmp_ge_u32 s44, 0x80000
    s_cbranch_scc1 L_flags_to
L_poll_chk:
    s_waitcnt lgkmcnt(0)
    s_cmp_lg_u64 s[16:17], s[60:61]
    s_cbranch_scc1 L_poll
    s_cmp_lg_u64 s[18:19], s[60:61]
    s_cbranch_scc1 L_poll
    s_cmp_lg_u64 s[20:21], s[60:61]
    s_cbranch_scc1 L_poll
    s_cmp_lg_u32 s22, s60
    s_cbranch_scc1 L_poll
L_flags_to:
    s_waitcnt lgkmcnt(0)
    s_bfe_u32 s58, s48, 0x30000
    s_lshl_b32 s58, s58, 13
    s_add_u32 s58, s58, s56
    s_add_u32 s59, s58, 4096
    buffer_load_dwordx4 v[112:115], v44, s[28:31], s58 offen sc1
    buffer_load_dwordx4 v[116:119], v45, s[28:31], s58 offen sc1
    buffer_load_dwordx4 v[120:123], v44, s[28:31], s58 offen offset:2048 sc1
    buffer_load_dwordx4 v[124:127], v45, s[28:31], s58 offen offset:2048 sc1
    buffer_load_dwordx4 v[128:131], v44, s[28:31], s59 offen sc1
    buffer_load_dwordx4 v[132:135], v45, s[28:31], s59 offen sc1
    buffer_load_dwordx4 v[136:139], v44, s[28:31], s59 offen offset:2048 sc1
    buffer_load_dwordx4 v[140:143], v45, s[28:31], s59 offen offset:2048 sc1
    s_bfe_u32 s58, s48, 0x30004
    s_lshl_b32 s58, s58, 13
    s_add_u32 s58, s58, s56
    s_add_u32 s59, s58, 4096
    buffer_load_dwordx4 v[144:147], v44, s[28:31], s58 offen sc1
    buffer_load_dwordx4 v[148:151], v45, s[28:31], s58 offen sc1
    s_waitcnt vmcnt(9)
    v_mfma_f32_32x32x16_bf16 v[48:63], v[192:195], v[112:115], 0
    buffer_load_dwordx4 v[152:155], v44, s[28:31], s58 offen offset:2048 sc1
    v_mfma_f32_32x32x16_bf16 v[80:95], v[196:199], v[112:115], 0
    s_waitcnt vmcnt(9)
    v_mfma_f32_32x32x16_bf16 v[96:111], v[196:199], v[116:119], 0
    buffer_load_dwordx4 v[156:159], v45, s[28:31], s58 offen offset:2048 sc1
    v_mfma_f32_32x32x16_bf16 v[64:79], v[192:195], v[116:119], 0
    s_waitcnt vmcnt(9)
    v_mfma_f32_32x32x16_bf16 v[48:63], v[200:203], v[120:123], v[48:63]
    buffer_load_dwordx4 v[112:115], v44, s[28:31], s59 offen sc1
    v_mfma_f32_32x32x16_bf16 v[80:95], v[204:207], v[120:123], v[80:95]
    s_waitcnt vmcnt(9)
    v_mfma_f32_32x32x16_bf16 v[96:111], v[204:207], v[124:127], v[96:111]
    buffer_load_dwordx4 v[116:119], v45, s[28:31], s59 offen sc1
    v_mfma_f32_32x32x16_bf16 v[64:79], v[200:203], v[124:127], v[64:79]
    s_waitcnt vmcnt(9)
    v_mfma_f32_32x32x16_bf16 v[48:63], v[208:211], v[128:131], v[48:63]
    buffer_load_dwordx4 v[120:123], v44, s[28:31], s59 offen offset:2048 sc1
    v_mfma_f32_32x32x16_bf16 v[80:95], v[212:215], v[128:131], v[80:95]
    s_waitcnt vmcnt(9)
    v_mfma_f32_32x32x16_bf16 v[96:111], v[212:215], v[132:135], v[96:111]
    buffer_load_dwordx4 v[124:127], v45, s[28:31], s59 offen offset:2048 sc1
    v_mfma_f32_32x32x16_bf16 v[64:79], v[208:211], v[132:135], v[64:79]
    s_waitcnt vmcnt(9)
    s_bfe_u32 s58, s48, 0x30008
    s_lshl_b32 s58, s58, 13
    s_add_u32 s58, s58, s56
    s_add_u32 s59, s58, 4096
    v_mfma_f32_32x32x16_bf16 v[48:63], v[216:219], v[136:139], v[48:63]
    buffer_load_dwordx4 v[128:131], v44, s[28:31], s58 offen sc1
    v_mfma_f32_32x32x16_bf16 v[80:95], v[220:223], v[136:139], v[80:95]
    s_waitcnt vmcnt(9)
    v_mfma_f32_32x32x16_bf16 v[96:111], v[220:223], v[140:143], v[96:111]
    buffer_load_dwordx4 v[132:135], v45, s[28:31], s58 offen sc1
    v_mfma_f32_32x32x16_bf16 v[64:79], v[216:219], v[140:143], v[64:79]
    s_waitcnt vmcnt(9)
    v_mfma_f32_32x32x16_bf16 v[48:63], v[224:227], v[144:147], v[48:63]
    buffer_load_dwordx4 v[136:139], v44, s[28:31], s58 offen offset:2048 sc1
    v_mfma_f32_32x32x16_bf16 v[80:95], v[228:231], v[144:147], v[80:95]
    s_waitcnt vmcnt(9)
    v_mfma_f32_32x32x16_bf16 v[96:111], v[228:231], v[148:151], v[96:111]
    buffer_load_dwordx4 v[140:143], v45, s[28:31], s58 offen offset:2048 sc1
    v_mfma_f32_32x32x16_bf16 v[64:79], v[224:227], v[148:151], v[64:79]
    s_waitcnt vmcnt(9)
    v_mfma_f32_32x32x16_bf16 v[48:63], v[232:235], v[152:155], v[48:63]
    buffer_load_dwordx4 v[144:147], v44, s[28:31], s59 offen sc1
    v_mfma_f32_32x32x16_bf16 v[80:95], v[236:239], v[152:155], v[80:95]
    s_waitcnt vmcnt(9)
    v_mfma_f32_32x32x16_bf16 v[96:111], v[236:239], v[156:159], v[96:111]
    buffer_load_dwordx4 v[148:151], v45, s[28:31], s59 offen sc1
    v_mfma_f32_32x32x16_bf16 v[64:79], v[232:235], v[156:159], v[64:79]
    ds_read_b64_tr_b16 v[160:161], v42 offset:0
    ds_read_b64_tr_b16 v[162:163], v42 offset:1024
    ds_read_b64_tr_b16 v[164:165], v43 offset:0
    ds_read_b64_tr_b16 v[166:167], v43 offset:1024
    s_waitcnt vmcnt(9)
    v_mfma_f32_32x32x16_bf16 v[48:63], v[240:243], v[112:115], v[48:63]
    buffer_load_dwordx4 v[152:155], v44, s[28:31], s59 offen offset:2048 sc1
    v_mfma_f32_32x32x16_bf16 v[80:95], v[244:247], v[112:115], v[80:95]
    s_waitcnt vmcnt(9)
    v_mfma_f32_32x32x16_bf16 v[96:111], v[244:247], v[116:119], v[96:111]
    buffer_load_dwordx4 v[156:159], v45, s[28:31], s59 offen offset:2048 sc1
    v_mfma_f32_32x32x16_bf16 v[64:79], v[240:243], v[116:119], v[64:79]
    ds_read_b64_tr_b16 v[168:169], v42 offset:2048
    ds_read_b64_tr_b16 v[170:171], v42 offset:3072
    ds_read_b64_tr_b16 v[172:173], v43 offset:2048
    ds_read_b64_tr_b16 v[174:175], v43 offset:3072
    s_waitcnt vmcnt(9)
    s_bfe_u32 s58, s48, 0x3000c
    s_lshl_b32 s58, s58, 13
    s_add_u32 s58, s58, s56
    s_add_u32 s59, s58, 4096
    v_mfma_f32_32x32x16_bf16 v[48:63], v[248:251], v[120:123], v[48:63]
    buffer_load_dwordx4 v[112:115], v44, s[28:31], s58 offen sc1
    v_mfma_f32_32x32x16_bf16 v[80:95], v[252:255], v[120:123], v[80:95]
    s_waitcnt vmcnt(9)
    v_mfma_f32_32x32x16_bf16 v[96:111], v[252:255], v[124:127], v[96:111]
    buffer_load_dwordx4 v[116:119], v45, s[28:31], s58 offen sc1
    v_mfma_f32_32x32x16_bf16 v[64:79], v[248:251], v[124:127], v[64:79]
    ds_read_b64_tr_b16 v[176:177], v42 offset:4096
    ds_read_b64_tr_b16 v[178:179], v42 offset:5120
    ds_read_b64_tr_b16 v[180:181], v43 offset:4096
    ds_read_b64_tr_b16 v[182:183], v43 offset:5120
    s_waitcnt vmcnt(9)
    s_waitcnt lgkmcnt(8)
    v_mfma_f32_32x32x16_bf16 v[48:63], v[160:163], v[128:131], v[48:63]
    buffer_load_dwordx4 v[120:123], v44, s[28:31], s58 offen offset:2048 sc1
    v_mfma_f32_32x32x16_bf16 v[80:95], v[164:167], v[128:131], v[80:95]
    s_waitcnt vmcnt(9)
    v_mfma_f32_32x32x16_bf16 v[96:111], v[164:167], v[132:135], v[96:111]
    buffer_load_dwordx4 v[124:127], v45, s[28:31], s58 offen offset:2048 sc1
    v_mfma_f32_32x32x16_bf16 v[64:79], v[160:163], v[132:135], v[64:79]
    ds_read_b64_tr_b16 v[184:185], v42 offset:6144
    ds_read_b64_tr_b16 v[186:187], v42 offset:7168
    ds_read_b64_tr_b16 v[188:189], v43 offset:6144
    ds_read_b64_tr_b16 v[190:191], v43 offset:7168
    s_waitcnt vmcnt(9)
    s_waitcnt lgkmcnt(8)
    v_mfma_f32_32x32x16_bf16 v[48:63], v[168:171], v[136:139], v[48:63]
    buffer_load_dwordx4 v[128:131], v44, s[28:31], s59 offen sc1
    v_mfma_f32_32x32x16_bf16 v[80:95], v[172:175], v[136:139], v[80:95]
    s_waitcnt vmcnt(9)
    v_mfma_f32_32x32x16_bf16 v[96:111], v[172:175], v[140:143], v[96:111]
    buffer_load_dwordx4 v[132:135], v45, s[28:31], s59 offen sc1
    v_mfma_f32_32x32x16_bf16 v[64:79], v[168:171], v[140:143], v[64:79]
    ds_read_b64_tr_b16 v[160:161], v28 offset:0
    ds_read_b64_tr_b16 v[162:163], v28 offset:1024
    ds_read_b64_tr_b16 v[164:165], v29 offset:0
    ds_read_b64_tr_b16 v[166:167], v29 offset:1024
    s_waitcnt vmcnt(9)
    s_waitcnt lgkmcnt(8)
    v_mfma_f32_32x32x16_bf16 v[48:63], v[176:179], v[144:147], v[48:63]
    buffer_load_dwordx4 v[136:139], v44, s[28:31], s59 offen offset:2048 sc1
    v_mfma_f32_32x32x16_bf16 v[80:95], v[180:183], v[144:147], v[80:95]
    s_waitcnt vmcnt(9)
    v_mfma_f32_32x32x16_bf16 v[96:111], v[180:183], v[148:151], v[96:111]
    buffer_load_dwordx4 v[140:143], v45, s[28:31], s59 offen offset:2048 sc1
    v_mfma_f32_32x32x16_bf16 v[64:79], v[176:179], v[148:151], v[64:79]
    ds_read_b64_tr_b16 v[168:169], v28 offset:2048
    ds_read_b64_tr_b16 v[170:171], v28 offset:3072
    ds_read_b64_tr_b16 v[172:173], v29 offset:2048
    ds_read_b64_tr_b16 v[174:175], v29 offset:3072
    s_waitcnt vmcnt(9)
    s_waitcnt lgkmcnt(8)
    s_bfe_u32 s58, s48, 0x30010
    s_lshl_b32 s58, s58, 13
    s_add_u32 s58, s58, s56
    s_add_u32 s59, s58, 4096
    v_mfma_f32_32x32x16_bf16 v[48:63], v[184:187], v[152:155], v[48:63]
    buffer_load_dwordx4 v[144:147], v44, s[28:31], s58 offen sc1
    v_mfma_f32_32x32x16_bf16 v[80:95], v[188:191], v[152:155], v[80:95]
    s_waitcnt vmcnt(9)
    v_mfma_f32_32x32x16_bf16 v[96:111], v[188:191], v[156:159], v[96:111]
    buffer_load_dwordx4 v[148:151], v45, s[28:31], s58 offen sc1
    v_mfma_f32_32x32x16_bf16 v[64:79], v[184:187], v[156:159], v[64:79]
    ds_read_b64_tr_b16 v[176:177], v28 offset:4096
    ds_read_b64_tr_b16 v[178:179], v28 offset:5120
    ds_read_b64_tr_b16 v[180:181], v29 offset:4096
    ds_read_b64_tr_b16 v[182:183], v29 offset:5120
    s_waitcnt vmcnt(9)
    s_waitcnt lgkmcnt(8)
    v_mfma_f32_32x32x16_bf16 v[48:63], v[160:163], v[112:115], v[48:63]
    buffer_load_dwordx4 v[152:155], v44, s[28:31], s58 offen offset:2048 sc1
    v_mfma_f32_32x32x16_bf16 v[80:95], v[164:167], v[112:115], v[80:95]
    s_waitcnt vmcnt(9)
    v_mfma_f32_32x32x16_bf16 v[96:111], v[164:167], v[116:119], v[96:111]
    buffer_load_dwordx4 v[156:159], v45, s[28:31], s58 offen offset:2048 sc1
    v_mfma_f32_32x32x16_bf16 v[64:79], v[160:163], v[116:119], v[64:79]
    ds_read_b64_tr_b16 v[184:185], v28 offset:6144
    ds_read_b64_tr_b16 v[186:187], v28 offset:7168
    ds_read_b64_tr_b16 v[188:189], v29 offset:6144
    ds_read_b64_tr_b16 v[190:191], v29 offset:7168
    s_waitcnt vmcnt(9)
    s_waitcnt lgkmcnt(8)
    v_mfma_f32_32x32x16_bf16 v[48:63], v[168:171], v[120:123], v[48:63]
    buffer_load_dwordx4 v[112:115], v44, s[28:31], s59 offen sc1
    v_mfma_f32_32x32x16_bf16 v[80:95], v[172:175], v[120:123], v[80:95]
    s_waitcnt vmcnt(9)
    v_mfma_f32_32x32x16_bf16 v[96:111], v[172:175], v[124:127], v[96:111]
    buffer_load_dwordx4 v[116:119], v45, s[28:31], s59 offen sc1
    v_mfma_f32_32x32x16_bf16 v[64:79], v[168:171], v[124:127], v[64:79]
    ds_read_b64_tr_b16 v[160:161], v28 offset:32768
    ds_read_b64_tr_b16 v[162:163], v28 offset:33792
    ds_read_b64_tr_b16 v[164:165], v29 offset:32768
    ds_read_b64_tr_b16 v[166:167], v29 offset:33792
    s_waitcnt vmcnt(9)
    s_waitcnt lgkmcnt(8)
    v_mfma_f32_32x32x16_bf16 v[48:63], v[176:179], v[128:131], v[48:63]
    buffer_load_dwordx4 v[120:123], v44, s[28:31], s59 offen offset:2048 sc1
    v_mfma_f32_32x32x16_bf16 v[80:95], v[180:183], v[128:131], v[80:95]
    s_waitcnt vmcnt(9)
    v_mfma_f32_32x32x16_bf16 v[96:111], v[180:183], v[132:135], v[96:111]
    buffer_load_dwordx4 v[124:127], v45, s[28:31], s59 offen offset:2048 sc1
    v_mfma_f32_32x32x16_bf16 v[64:79], v[176:179], v[132:135], v[64:79]
    ds_read_b64_tr_b16 v[168:169], v28 offset:34816
    ds_read_b64_tr_b16 v[170:171], v28 offset:35840
    ds_read_b64_tr_b16 v[172:173], v29 offset:34816
    ds_read_b64_tr_b16 v[174:175], v29 offset:35840
    s_waitcnt vmcnt(9)
    s_waitcnt lgkmcnt(8)
    s_bfe_u32 s58, s48, 0x30014
    s_lshl_b32 s58, s58, 13
    s_add_u32 s58, s58, s56
    s_add_u32 s59, s58, 4096
    v_mfma_f32_32x32x16_bf16 v[48:63], v[184:187], v[136:139], v[48:63]
    buffer_load_dwordx4 v[128:131], v44, s[28:31], s58 offen sc1
    v_mfma_f32_32x32x16_bf16 v[80:95], v[188:191], v[136:139], v[80:95]
    s_waitcnt vmcnt(9)
    v_mfma_f32_32x32x16_bf16 v[96:111], v[188:191], v[140:143], v[96:111]
    buffer_load_dwordx4 v[132:135], v45, s[28:31], s58 offen sc1
    v_mfma_f32_32x32x16_bf16 v[64:79], v[184:187], v[140:143], v[64:79]
    ds_read_b64_tr_b16 v[176:177], v28 offset:36864
    ds_read_b64_tr_b16 v[178:179], v28 offset:37888
    ds_read_b64_tr_b16 v[180:181], v29 offset:36864
    ds_read_b64_tr_b16 v[182:183], v29 offset:37888
    s_waitcnt vmcnt(9)
    s_waitcnt lgkmcnt(8)
    v_mfma_f32_32x32x16_bf16 v[48:63], v[160:163], v[144:147], v[48:63]
    buffer_load_dwordx4 v[136:139], v44, s[28:31], s58 offen offset:2048 sc1
    v_mfma_f32_32x32x16_bf16 v[80:95], v[164:167], v[144:147], v[80:95]
    s_waitcnt vmcnt(9)
    v_mfma_f32_32x32x16_bf16 v[96:111], v[164:167], v[148:151], v[96:111]
    buffer_load_dwordx4 v[140:143], v45, s[28:31], s58 offen offset:2048 sc1
    v_mfma_f32_32x32x16_bf16 v[64:79], v[160:163], v[148:151], v[64:79]
    ds_read_b64_tr_b16 v[184:185], v28 offset:38912
    ds_read_b64_tr_b16 v[186:187], v28 offset:39936
    ds_read_b64_tr_b16 v[188:189], v29 offset:38912
    ds_read_b64_tr_b16 v[190:191], v29 offset:39936
    s_waitcnt vmcnt(9)
    s_waitcnt lgkmcnt(8)
    v_mfma_f32_32x32x16_bf16 v[48:63], v[168:171], v[152:155], v[48:63]
    buffer_load_dwordx4 v[144:147], v44, s[28:31], s59 offen sc1
    v_mfma_f32_32x32x16_bf16 v[80:95], v[172:175], v[152:155], v[80:95]
    s_waitcnt vmcnt(9)
    v_mfma_f32_32x32x16_bf16 v[96:111], v[172:175], v[156:159], v[96:111]
    buffer_load_dwordx4 v[148:151], v45, s[28:31], s59 offen sc1
    v_mfma_f32_32x32x16_bf16 v[64:79], v[168:171], v[156:159], v[64:79]
    ds_read_b64_tr_b16 v[160:161], v40 offset:0
    ds_read_b64_tr_b16 v[162:163], v40 offset:1024
    ds_read_b64_tr_b16 v[164:165], v41 offset:0
    ds_read_b64_tr_b16 v[166:167], v41 offset:1024
    s_waitcnt vmcnt(9)
    s_waitcnt lgkmcnt(8)
    v_mfma_f32_32x32x16_bf16 v[48:63], v[176:179], v[112:115], v[48:63]
    buffer_load_dwordx4 v[152:155], v44, s[28:31], s59 offen offset:2048 sc1
    v_mfma_f32_32x32x16_bf16 v[80:95], v[180:183], v[112:115], v[80:95]
    s_waitcnt vmcnt(9)
    v_mfma_f32_32x32x16_bf16 v[96:111], v[180:183], v[116:119], v[96:111]
    buffer_load_dwordx4 v[156:159], v45, s[28:31], s59 offen offset:2048 sc1
    v_mfma_f32_32x32x16_bf16 v[64:79], v[176:179], v[116:119], v[64:79]
    ds_read_b64_tr_b16 v[168:169], v40 offset:2048
    ds_read_b64_tr_b16 v[170:171], v40 offset:3072
    ds_read_b64_tr_b16 v[172:173], v41 offset:2048
    ds_read_b64_tr_b16 v[174:175], v41 offset:3072
    s_waitcnt vmcnt(9)
    s_waitcnt lgkmcnt(8)
    s_bfe_u32 s58, s48, 0x30018
    s_lshl_b32 s58, s58, 13
    s_add_u32 s58, s58, s56
    s_add_u32 s59, s58, 4096
    v_mfma_f32_32x32x16_bf16 v[48:63], v[184:187], v[120:123], v[48:63]
    buffer_load_dwordx4 v[112:115], v44, s[28:31], s58 offen sc1
    v_mfma_f32_32x32x16_bf16 v[80:95], v[188:191], v[120:123], v[80:95]
    s_waitcnt vmcnt(9)
    v_mfma_f32_32x32x16_bf16 v[96:111], v[188:191], v[124:127], v[96:111]
    buffer_load_dwordx4 v[116:119], v45, s[28:31], s58 offen sc1
    v_mfma_f32_32x32x16_bf16 v[64:79], v[184:187], v[124:127], v[64:79]
    ds_read_b64_tr_b16 v[176:177], v40 offset:4096
    ds_read_b64_tr_b16 v[178:179], v40 offset:5120
    ds_read_b64_tr_b16 v[180:181], v41 offset:4096
    ds_read_b64_tr_b16 v[182:183], v41 offset:5120
    s_waitcnt vmcnt(9)
    s_waitcnt lgkmcnt(8)
    v_mfma_f32_32x32x16_bf16 v[48:63], v[160:163], v[128:131], v[48:63]
    buffer_load_dwordx4 v[120:123], v44, s[28:31], s58 offen offset:2048 sc1
    v_mfma_f32_32x32x16_bf16 v[80:95], v[164:167], v[128:131], v[80:95]
    s_waitcnt vmcnt(9)
    v_mfma_f32_32x32x16_bf16 v[96:111], v[164:167], v[132:135], v[96:111]
    buffer_load_dwordx4 v[124:127], v45, s[28:31], s58 offen offset:2048 sc1
    v_mfma_f32_32x32x16_bf16 v[64:79], v[160:163], v[132:135], v[64:79]
    ds_read_b64_tr_b16 v[184:185], v40 offset:6144
    ds_read_b64_tr_b16 v[186:187], v40 offset:7168
    ds_read_b64_tr_b16 v[188:189], v41 offset:6144
    ds_read_b64_tr_b16 v[190:191], v41 offset:7168
    s_waitcnt vmcnt(9)
    s_waitcnt lgkmcnt(8)
    v_mfma_f32_32x32x16_bf16 v[48:63], v[168:171], v[136:139], v[48:63]
    buffer_load_dwordx4 v[128:131], v44, s[28:31], s59 offen sc1
    v_mfma_f32_32x32x16_bf16 v[80:95], v[172:175], v[136:139], v[80:95]
    s_waitcnt vmcnt(9)
    v_mfma_f32_32x32x16_bf16 v[96:111], v[172:175], v[140:143], v[96:111]
    buffer_load_dwordx4 v[132:135], v45, s[28:31], s59 offen sc1
    v_mfma_f32_32x32x16_bf16 v[64:79], v[168:171], v[140:143], v[64:79]
    ds_read_b64_tr_b16 v[160:161], v40 offset:32768
    ds_read_b64_tr_b16 v[162:163], v40 offset:33792
    ds_read_b64_tr_b16 v[164:165], v41 offset:32768
    ds_read_b64_tr_b16 v[166:167], v41 offset:33792
    s_waitcnt vmcnt(9)
    s_waitcnt lgkmcnt(8)
    v_mfma_f32_32x32x16_bf16 v[48:63], v[176:179], v[144:147], v[48:63]
    buffer_load_dwordx4 v[136:139], v44, s[28:31], s59 offen offset:2048 sc1
    v_mfma_f32_32x32x16_bf16 v[80:95], v[180:183], v[144:147], v[80:95]
    s_waitcnt vmcnt(9)
    v_mfma_f32_32x32x16_bf16 v[96:111], v[180:183], v[148:151], v[96:111]
    buffer_load_dwordx4 v[140:143], v45, s[28:31], s59 offen offset:2048 sc1
    v_mfma_f32_32x32x16_bf16 v[64:79], v[176:179], v[148:151], v[64:79]
    ds_read_b64_tr_b16 v[168:169], v40 offset:34816
    ds_read_b64_tr_b16 v[170:171], v40 offset:35840
    ds_read_b64_tr_b16 v[172:173], v41 offset:34816
    ds_read_b64_tr_b16 v[174:175], v41 offset:35840
    s_waitcnt vmcnt(9)
    s_waitcnt lgkmcnt(8)
    v_mfma_f32_32x32x16_bf16 v[48:63], v[184:187], v[152:155], v[48:63]
    v_mfma_f32_32x32x16_bf16 v[80:95], v[188:191], v[152:155], v[80:95]
    s_waitcnt vmcnt(8)
    v_mfma_f32_32x32x16_bf16 v[96:111], v[188:191], v[156:159], v[96:111]
    v_mfma_f32_32x32x16_bf16 v[64:79], v[184:187], v[156:159], v[64:79]
    ds_read_b64_tr_b16 v[176:177], v40 offset:36864
    ds_read_b64_tr_b16 v[178:179], v40 offset:37888
    ds_read_b64_tr_b16 v[180:181], v41 offset:36864
    ds_read_b64_tr_b16 v[182:183], v41 offset:37888
    s_waitcnt vmcnt(7)
    s_waitcnt lgkmcnt(8)
    v_mfma_f32_32x32x16_bf16 v[48:63], v[160:163], v[112:115], v[48:63]
    v_mfma_f32_32x32x16_bf16 v[80:95], v[164:167], v[112:115], v[80:95]
    s_waitcnt vmcnt(6)
    v_mfma_f32_32x32x16_bf16 v[96:111], v[164:167], v[116:119], v[96:111]
    v_mfma_f32_32x32x16_bf16 v[64:79], v[160:163], v[116:119], v[64:79]
    ds_read_b64_tr_b16 v[184:185], v40 offset:38912
    ds_read_b64_tr_b16 v[186:187], v40 offset:39936
    ds_read_b64_tr_b16 v[188:189], v41 offset:38912
    ds_read_b64_tr_b16 v[190:191], v41 offset:39936
    s_waitcnt vmcnt(5)
    s_waitcnt lgkmcnt(8)
    v_mfma_f32_32x32x16_bf16 v[48:63], v[168:171], v[120:123], v[48:63]
    v_mfma_f32_32x32x16_bf16 v[80:95], v[172:175], v[120:123], v[80:95]
    s_waitcnt vmcnt(4)
    v_mfma_f32_32x32x16_bf16 v[96:111], v[172:175], v[124:127], v[96:111]
    v_mfma_f32_32x32x16_bf16 v[64:79], v[168:171], v[124:127], v[64:79]
    s_waitcnt lgkmcnt(0)
    s_waitcnt vmcnt(3)
    v_mfma_f32_32x32x16_bf16 v[80:95], v[180:183], v[128:131], v[80:95]
    s_waitcnt vmcnt(2)
    v_mfma_f32_32x32x16_bf16 v[96:111], v[180:183], v[132:135], v[96:111]
    v_mfma_f32_32x32x16_bf16 v[64:79], v[176:179], v[132:135], v[64:79]
    s_waitcnt vmcnt(1)
    v_mfma_f32_32x32x16_bf16 v[80:95], v[188:191], v[136:139], v[80:95]
    s_waitcnt vmcnt(0)
    v_mfma_f32_32x32x16_bf16 v[96:111], v[188:191], v[140:143], v[96:111]
    v_mfma_f32_32x32x16_bf16 v[64:79], v[184:187], v[140:143], v[64:79]
    v_mfma_f32_32x32x16_bf16 v[48:63], v[176:179], v[128:131], v[48:63]
    s_nop 8
    ds_write_b128 v11, v[80:83] offset:0
    ds_write_b128 v11, v[84:87] offset:1024
    ds_write_b128 v11, v[88:91] offset:2048
    ds_write_b128 v11, v[92:95] offset:3072
    v_mfma_f32_32x32x16_bf16 v[48:63], v[184:187], v[136:139], v[48:63]
    ds_write_b128 v11, v[96:99] offset:32768
    ds_write_b128 v11, v[100:103] offset:33792
    ds_write_b128 v11, v[104:107] offset:34816
    ds_write_b128 v11, v[108:111] offset:35840
    ds_write_b128 v10, v[64:67] offset:32768
    ds_write_b128 v10, v[68:71] offset:33792
    ds_write_b128 v10, v[72:75] offset:34816
    ds_write_b128 v10, v[76:79] offset:35840
    s_waitcnt lgkmcnt(0)
    s_barrier
    ds_read_b128 v[192:195], v12 offset:32768
    ds_read_b128 v[208:211], v13 offset:0
    ds_read_b128 v[224:227], v14 offset:32768
    ds_read_b128 v[196:199], v12 offset:33792
    ds_read_b128 v[212:215], v13 offset:1024
    ds_read_b128 v[228:231], v14 offset:33792
    ds_read_b128 v[200:203], v12 offset:34816
    ds_read_b128 v[216:219], v13 offset:2048
    ds_read_b128 v[232:235], v14 offset:34816
    ds_read_b128 v[204:207], v12 offset:35840
    ds_read_b128 v[220:223], v13 offset:3072
    ds_read_b128 v[236:239], v14 offset:35840
    s_waitcnt lgkmcnt(9)
    v_add_f32 v192, v192, v208
    v_add_f32 v48, v48, v224
    v_add_f32 v193, v193, v209
    v_add_f32 v49, v49, v225
    v_add_f32 v194, v194, v210
    v_add_f32 v50, v50, v226
    v_add_f32 v195, v195, v211
    v_add_f32 v51, v51, v227
    v_add_f32 v48, v48, v192
    v_add_f32 v49, v49, v193
    v_add_f32 v50, v50, v194
    v_add_f32 v51, v51, v195
    v_cvt_pk_bf16_f32 v240, v48, v49
    v_cvt_pk_bf16_f32 v241, v50, v51
    s_waitcnt lgkmcnt(6)
    v_add_f32 v196, v196, v212
    v_add_f32 v52, v52, v228
    v_add_f32 v197, v197, v213
    v_add_f32 v53, v53, v229
    v_add_f32 v198, v198, v214
    v_add_f32 v54, v54, v230
    v_add_f32 v199, v199, v215
    v_add_f32 v55, v55, v231
    v_add_f32 v52, v52, v196
    v_add_f32 v53, v53, v197
    v_add_f32 v54, v54, v198
    v_add_f32 v55, v55, v199
    v_cvt_pk_bf16_f32 v242, v52, v53
    v_cvt_pk_bf16_f32 v243, v54, v55
    s_nop 1
    v_permlane32_swap_b32 v240, v242
    v_permlane32_swap_b32 v241, v243
    buffer_store_dwordx4 v[240:243], v38, s[32:35], s99 offen
    s_waitcnt lgkmcnt(3)
    v_add_f32 v200, v200, v216
    v_add_f32 v56, v56, v232
    v_add_f32 v201, v201, v217
    v_add_f32 v57, v57, v233
    v_add_f32 v202, v202, v218
    v_add_f32 v58, v58, v234
    v_add_f32 v203, v203, v219
    v_add_f32 v59, v59, v235
    v_add_f32 v56, v56, v200
    v_add_f32 v57, v57, v201
    v_add_f32 v58, v58, v202
    v_add_f32 v59, v59, v203
    v_cvt_pk_bf16_f32 v244, v56, v57
    v_cvt_pk_bf16_f32 v245, v58, v59
    s_waitcnt lgkmcnt(0)
    v_add_f32 v204, v204, v220
    v_add_f32 v60, v60, v236
    v_add_f32 v205, v205, v221
    v_add_f32 v61, v61, v237
    v_add_f32 v206, v206, v222
    v_add_f32 v62, v62, v238
    v_add_f32 v207, v207, v223
    v_add_f32 v63, v63, v239
    v_add_f32 v60, v60, v204
    v_add_f32 v61, v61, v205
    v_add_f32 v62, v62, v206
    v_add_f32 v63, v63, v207
    v_cvt_pk_bf16_f32 v246, v60, v61
    v_cvt_pk_bf16_f32 v247, v62, v63
    s_nop 1
    v_permlane32_swap_b32 v244, v246
    v_permlane32_swap_b32 v245, v247
    buffer_store_dwordx4 v[244:247], v38, s[32:35], s99 offen offset:32
    s_endpgm
L_code_end:
.section .rodata,"a"
.p2align 6
.amdhsa_kernel standalone__dense_activation_relu__prompt_kernel
  .amdhsa_next_free_vgpr 256
  .amdhsa_next_free_sgpr 102
  .amdhsa_accum_offset 256
  .amdhsa_group_segment_fixed_size 0
  .amdhsa_kernarg_size 48
  .amdhsa_user_sgpr_count 2
  .amdhsa_user_sgpr_kernarg_segment_ptr 1
  .amdhsa_system_sgpr_workgroup_id_x 1
.end_amdhsa_kernel
```
